```python
import torch

def _softmax(x, axis=-1):
    return torch.softmax(x, dim=axis)
def _gelu(x):
    return torch.nn.functional.gelu(x, approximate="tanh")
def _silu(x):
    return torch.nn.functional.silu(x)
def _sigmoid(x):
    return torch.sigmoid(x)
def _layernorm(x, axis=-1, eps=1e-5):
    m = x.mean(dim=axis, keepdim=True)
    v = x.var(dim=axis, keepdim=True, unbiased=False)
    return (x - m) / torch.sqrt(v + eps)
def _scatter_add(tgt, idx, src, axis=0):
    return tgt.clone().index_add_(axis, idx, src)
def _segment_sum(src, seg, n):
    out = torch.zeros((n,) + src.shape[1:], dtype=src.dtype)
    return out.index_add_(0, seg, src)
def _pad(x, pw):
    flat = tuple(v for pair in reversed(pw) for v in pair)
    return torch.nn.functional.pad(x, flat)

kernel_name = 'concat_heads__gqa_block_cached__gqa_block_cached__decode'

def setup_inputs():

    _w = (lambda a: (lambda t: t.to(torch.bfloat16) if t.is_floating_point() else t)(torch.as_tensor(a)))
    def _A_setup():
        B, Sq, D = 4, 1, 512
        Hq, Hkv, Sk, Dh = 32, 8, 4096, 128
        assert Hq % Hkv == 0, (Hq, Hkv)
        return {
            "x": _w((lambda *s: torch.randn(*s, dtype=torch.bfloat16) * 0.8)(B, Sq, D)),
            "k_cache": _w((lambda *s: torch.randn(*s, dtype=torch.bfloat16) * 0.8)(B, Hkv, Sk, Dh)),
            "v_cache": _w((lambda *s: torch.randn(*s, dtype=torch.bfloat16) * 0.05)(B, Hkv, Sk, Dh)),
            "wq": _w((lambda *s: torch.randn(*s, dtype=torch.bfloat16) * 0.8)(D, Hq * Dh) * (D ** -0.5)),
            "wo": _w((lambda *s: torch.randn(*s, dtype=torch.bfloat16) * 0.05)(Hq * Dh, D) * ((Hq * Dh) ** -0.5)),
        }
    _A_in = _A_setup()

    def _B_setup():
        B, Sq, D = 4, 1, 512
        Hq, Hkv, Sk, Dh = 32, 8, 4096, 128
        assert Hq % Hkv == 0, (Hq, Hkv)
        return {
            "x": _w((lambda *s: torch.randn(*s, dtype=torch.bfloat16) * 0.8)(B, Sq, D)),
            "k_cache": _w((lambda *s: torch.randn(*s, dtype=torch.bfloat16) * 0.8)(B, Hkv, Sk, Dh)),
            "v_cache": _w((lambda *s: torch.randn(*s, dtype=torch.bfloat16) * 0.05)(B, Hkv, Sk, Dh)),
            "wq": _w((lambda *s: torch.randn(*s, dtype=torch.bfloat16) * 0.8)(D, Hq * Dh) * (D ** -0.5)),
            "wo": _w((lambda *s: torch.randn(*s, dtype=torch.bfloat16) * 0.05)(Hq * Dh, D) * ((Hq * Dh) ** -0.5)),
        }
    _B_in = _B_setup()

    return {
        "A_x": _A_in["x"],
        "A_k_cache": _A_in["k_cache"],
        "A_v_cache": _A_in["v_cache"],
        "A_wq": _A_in["wq"],
        "A_wo": _A_in["wo"],
        "B_x": _B_in["x"],
        "B_k_cache": _B_in["k_cache"],
        "B_v_cache": _B_in["v_cache"],
        "B_wq": _B_in["wq"],
        "B_wo": _B_in["wo"],
    }

def reference(A_x, A_k_cache, A_v_cache, A_wq, A_wo, B_x, B_k_cache, B_v_cache, B_wq, B_wo):
    def _A_ref(x, k_cache, v_cache, wq, wo):
        B, Sq, D = x.shape
        Hq, Dh = 32, 128
        Hkv = k_cache.shape[1]
        rep = Hq // Hkv
        q = (lambda x, *d: x.permute(*d))((x @ wq).reshape(B, Sq, Hq, Dh), 0, 2, 1, 3)
        k = (lambda x, n, axis: torch.repeat_interleave(x, n, dim=axis))(k_cache, rep, axis=1)
        v = (lambda x, n, axis: torch.repeat_interleave(x, n, dim=axis))(v_cache, rep, axis=1)
        scores = torch.einsum("bhqd,bhkd->bhqk", q, k) * (Dh ** -0.5)
        p = _softmax(scores, axis=-1)
        o = torch.einsum("bhqk,bhkd->bhqd", p, v)
        return (lambda x, *d: x.permute(*d))(o, 0, 2, 1, 3).reshape(B, Sq, Hq * Dh) @ wo

    def _B_ref(x, k_cache, v_cache, wq, wo):
        B, Sq, D = x.shape
        Hq, Dh = 32, 128
        Hkv = k_cache.shape[1]
        rep = Hq // Hkv
        q = (lambda x, *d: x.permute(*d))((x @ wq).reshape(B, Sq, Hq, Dh), 0, 2, 1, 3)
        k = (lambda x, n, axis: torch.repeat_interleave(x, n, dim=axis))(k_cache, rep, axis=1)
        v = (lambda x, n, axis: torch.repeat_interleave(x, n, dim=axis))(v_cache, rep, axis=1)
        scores = torch.einsum("bhqd,bhkd->bhqk", q, k) * (Dh ** -0.5)
        p = _softmax(scores, axis=-1)
        o = torch.einsum("bhqk,bhkd->bhqd", p, v)
        return (lambda x, *d: x.permute(*d))(o, 0, 2, 1, 3).reshape(B, Sq, Hq * Dh) @ wo

    a = _A_ref(A_x, A_k_cache, A_v_cache, A_wq, A_wo)
    b = _B_ref(B_x, B_k_cache, B_v_cache, B_wq, B_wo)
    return torch.concatenate([a, b], axis=-1)
```

```asm
; @launch grid=(256,1,1) block=(576,1,1) lds=156384
.amdgcn_target "amdgcn-amd-amdhsa--gfx950"
.text
.globl concat_heads__gqa_block_cached__gqa_block_cached__decode_kernel
.p2align 8
.type concat_heads__gqa_block_cached__gqa_block_cached__decode_kernel,@function
concat_heads__gqa_block_cached__gqa_block_cached__decode_kernel:
s_lshr_b32 s30, s2, 7
s_cmp_ge_u32 s30, 2
s_cbranch_scc1 L_end
s_mul_i32 s8, s30, 40
s_load_dwordx2 s[48:49], s[0:1], s8 offset:24
s_load_dwordx2 s[40:41], s[0:1], s8 offset:8
s_load_dwordx2 s[52:53], s[0:1], s8 offset:0
s_load_dwordx2 s[56:57], s[0:1], 96
v_lshrrev_b32 v1, 6, v0
v_and_b32 v15, 15, v0
v_readfirstlane_b32 s36, v1
v_bfe_u32 v14, v0, 4, 2
s_and_b32 s31, s2, 7
s_bfe_u32 s33, s2, 0x20005
s_bfe_u32 s34, s2, 0x20003
v_lshlrev_b32 v18, 15, v14
v_lshl_add_u32 v18, v15, 4, v18
s_mov_b32 s50, 0x400000
s_mov_b32 s51, 0x20000
s_lshl2_add_u32 s10, s31, s34
s_lshl_b32 s10, s10, 8
s_lshl3_add_u32 s9, s33, s36
s_lshl_b32 s12, s9, 17
s_add_u32 s10, s10, s12
s_cmp_eq_u32 s36, 8
s_cbranch_scc1 L_svc0
s_waitcnt lgkmcnt(0)
buffer_load_dwordx4 v[52:55], v18, s[48:51], s10 offen nt
s_add_u32 s10, s10, 8192
buffer_load_dwordx4 v[56:59], v18, s[48:51], s10 offen nt
s_add_u32 s10, s10, 8192
buffer_load_dwordx4 v[60:63], v18, s[48:51], s10 offen nt
s_add_u32 s10, s10, 8192
buffer_load_dwordx4 v[64:67], v18, s[48:51], s10 offen nt
s_load_dwordx2 s[44:45], s[0:1], s8 offset:16
s_load_dwordx2 s[4:5], s[0:1], s8 offset:32
v_and_b32 v0, 63, v0
v_and_b32 v19, 3, v0
v_lshlrev_b32 v19, 10, v19
v_lshl_add_u32 v19, v14, 3, v19
s_lshl_b32 s9, s9, 5
s_mov_b32 s54, 0x1000
s_mov_b32 s55, s51
buffer_load_dwordx2 v[16:17], v19, s[52:55], s9 offen
s_lshl3_add_u32 s11, s33, s31
s_lshl2_add_u32 s11, s11, s34
s_lshl_b32 s11, s11, 6
s_add_u32 s11, s11, s36
s_lshl_b32 s11, s11, 12
v_xor_b32 v1, v14, v15
v_lshlrev_b32 v1, 4, v1
v_lshl_add_u32 v2, v14, 8, v1
v_xor_b32 v3, 64, v2
v_xor_b32 v4, 128, v2
v_xor_b32 v5, 192, v2
s_lshl_b32 s13, s36, 14
s_mov_b32 m0, s13
s_mov_b32 s42, 0x2000000
s_mov_b32 s43, s51
s_barrier
buffer_load_dwordx4 v2, s[40:43], s11 offen offset:0 nt lds
buffer_load_dwordx4 v3, s[40:43], s11 offen offset:1024 nt lds
s_branch L_cont
L_svc0:
s_setprio 3
s_lshl_b32 s61, s30, 7
s_add_u32 s61, s61, 1703936
s_waitcnt lgkmcnt(0)
s_load_dword s60, s[56:57], s61
s_load_dwordx2 s[24:25], s[0:1], 80
s_barrier
s_branch L_svc1
L_cont:
s_lshl2_add_u32 s32, s33, s34
s_lshl3_add_u32 s35, s30, s31
s_mov_b32 s58, 0x3c0000
s_mov_b32 s59, s51
s_mov_b32 s3, 0x3ff
s_mov_b32 s46, s42
s_mov_b32 s47, s51
s_mov_b32 s6, s50
s_mov_b32 s7, s51
s_mov_b32 s38, 0x05040100
s_mov_b32 s39, 0x07060302
s_mov_b32 s37, 0x3e0293ee
v_lshl_add_u32 v7, v15, 8, v1
v_add_u32 v7, s13, v7
v_xor_b32 v8, 64, v7
v_xor_b32 v9, 128, v7
v_xor_b32 v10, 192, v7
v_lshlrev_b32 v6, 10, v14
v_lshl_add_u32 v6, v15, 4, v6
s_mul_i32 s14, s36, 2592
s_add_u32 s14, s14, 131072
v_lshlrev_b32 v11, 4, v15
v_add_u32 v11, s14, v11
s_lshr_b32 s16, 0x55, s31
s_and_b32 s16, s16, 1
s_mov_b32 s17, 0
s_mov_b64 vcc, s[16:17]
s_waitcnt vmcnt(2)
buffer_load_dwordx4 v4, s[40:43], s11 offen offset:2048 nt lds
buffer_load_dwordx4 v5, s[40:43], s11 offen offset:3072 nt lds
v_perm_b32 v36, v56, v52, s38
v_perm_b32 v37, v64, v60, s38
v_perm_b32 v38, v56, v52, s39
v_perm_b32 v39, v64, v60, s39
v_perm_b32 v40, v57, v53, s38
v_perm_b32 v41, v65, v61, s38
v_perm_b32 v42, v57, v53, s39
v_perm_b32 v43, v65, v61, s39
v_perm_b32 v44, v58, v54, s38
v_perm_b32 v45, v66, v62, s38
v_perm_b32 v46, v58, v54, s39
v_perm_b32 v47, v66, v62, s39
v_perm_b32 v48, v59, v55, s38
v_perm_b32 v49, v67, v63, s38
v_perm_b32 v50, v59, v55, s39
v_perm_b32 v51, v67, v63, s39
s_nop 1
v_mfma_f32_16x16x16_bf16 v[68:71], v[16:17], v[36:37], 0
v_mfma_f32_16x16x16_bf16 v[72:75], v[16:17], v[38:39], 0
v_mfma_f32_16x16x16_bf16 v[76:79], v[16:17], v[40:41], 0
v_mfma_f32_16x16x16_bf16 v[80:83], v[16:17], v[42:43], 0
v_mfma_f32_16x16x16_bf16 v[84:87], v[16:17], v[44:45], 0
v_mfma_f32_16x16x16_bf16 v[88:91], v[16:17], v[46:47], 0
v_mfma_f32_16x16x16_bf16 v[92:95], v[16:17], v[48:49], 0
v_mfma_f32_16x16x16_bf16 v[96:99], v[16:17], v[50:51], 0
s_mov_b64 exec, 0xffff
ds_write_b128 v11, v[68:71] offset:0
ds_write_b128 v11, v[72:75] offset:288
ds_write_b128 v11, v[76:79] offset:576
ds_write_b128 v11, v[80:83] offset:864
ds_write_b128 v11, v[84:87] offset:1152
ds_write_b128 v11, v[88:91] offset:1440
ds_write_b128 v11, v[92:95] offset:1728
ds_write_b128 v11, v[96:99] offset:2016
s_mov_b64 exec, -1
s_waitcnt lgkmcnt(0)
s_barrier
s_add_u32 s12, s13, 4096
s_mov_b32 m0, s12
s_add_u32 s12, s11, 32768
s_waitcnt vmcnt(3)
buffer_load_dwordx4 v2, s[40:43], s12 offen offset:0 nt lds
s_waitcnt vmcnt(3)
buffer_load_dwordx4 v3, s[40:43], s12 offen offset:1024 nt lds
s_waitcnt vmcnt(3)
buffer_load_dwordx4 v4, s[40:43], s12 offen offset:2048 nt lds
s_waitcnt vmcnt(3)
buffer_load_dwordx4 v5, s[40:43], s12 offen offset:3072 nt lds
s_add_u32 s12, s13, 8192
s_mov_b32 m0, s12
s_add_u32 s12, s11, 65536
s_waitcnt vmcnt(3)
buffer_load_dwordx4 v2, s[40:43], s12 offen offset:0 nt lds
s_waitcnt vmcnt(3)
buffer_load_dwordx4 v3, s[40:43], s12 offen offset:1024 nt lds
s_waitcnt vmcnt(3)
buffer_load_dwordx4 v4, s[40:43], s12 offen offset:2048 nt lds
s_waitcnt vmcnt(3)
buffer_load_dwordx4 v5, s[40:43], s12 offen offset:3072 nt lds
s_add_u32 s12, s13, 12288
s_mov_b32 m0, s12
s_add_u32 s12, s11, 98304
s_waitcnt vmcnt(3)
buffer_load_dwordx4 v2, s[40:43], s12 offen offset:0 nt lds
s_waitcnt vmcnt(3)
buffer_load_dwordx4 v3, s[40:43], s12 offen offset:1024 nt lds
s_waitcnt vmcnt(3)
buffer_load_dwordx4 v4, s[40:43], s12 offen offset:2048 nt lds
s_waitcnt vmcnt(3)
buffer_load_dwordx4 v5, s[40:43], s12 offen offset:3072 nt lds
s_add_u32 s15, s11, 0
s_waitcnt vmcnt(3)
buffer_load_dwordx4 v[100:103], v6, s[44:47], s15 offen offset:0 nt
s_waitcnt vmcnt(3)
buffer_load_dwordx4 v[104:107], v6, s[44:47], s15 offen offset:256 nt
s_waitcnt vmcnt(3)
buffer_load_dwordx4 v[108:111], v6, s[44:47], s15 offen offset:512 nt
s_waitcnt vmcnt(3)
buffer_load_dwordx4 v[112:115], v6, s[44:47], s15 offen offset:768 nt
s_add_u32 s15, s11, 32768
s_waitcnt vmcnt(3)
buffer_load_dwordx4 v[116:119], v6, s[44:47], s15 offen offset:0 nt
s_waitcnt vmcnt(3)
buffer_load_dwordx4 v[120:123], v6, s[44:47], s15 offen offset:256 nt
s_waitcnt vmcnt(3)
buffer_load_dwordx4 v[124:127], v6, s[44:47], s15 offen offset:512 nt
s_waitcnt vmcnt(3)
buffer_load_dwordx4 v[128:131], v6, s[44:47], s15 offen offset:768 nt
s_add_u32 s15, s11, 65536
s_waitcnt vmcnt(3)
buffer_load_dwordx4 v[132:135], v6, s[44:47], s15 offen offset:0 nt
s_waitcnt vmcnt(3)
buffer_load_dwordx4 v[136:139], v6, s[44:47], s15 offen offset:256 nt
s_waitcnt vmcnt(3)
buffer_load_dwordx4 v[140:143], v6, s[44:47], s15 offen offset:512 nt
s_waitcnt vmcnt(3)
buffer_load_dwordx4 v[144:147], v6, s[44:47], s15 offen offset:768 nt
s_add_u32 s15, s11, 98304
s_waitcnt vmcnt(3)
buffer_load_dwordx4 v[148:151], v6, s[44:47], s15 offen offset:0 nt
s_waitcnt vmcnt(3)
buffer_load_dwordx4 v[152:155], v6, s[44:47], s15 offen offset:256 nt
L_r1done:
v_and_b32 v1, 3, v0
v_lshlrev_b32 v1, 8, v1
v_lshl_add_u32 v1, v14, 4, v1
v_add_u32 v1, 151808, v1
s_barrier
ds_read_b128 v[20:23], v1 offset:0
ds_read_b128 v[24:27], v1 offset:64
ds_read_b128 v[28:31], v1 offset:128
ds_read_b128 v[32:35], v1 offset:192
s_waitcnt vmcnt(3)
buffer_load_dwordx4 v[156:159], v6, s[44:47], s15 offen offset:512 nt
s_waitcnt vmcnt(27)
ds_read_b128 v[36:39], v7 offset:0
ds_read_b128 v[40:43], v8 offset:0
ds_read_b128 v[44:47], v9 offset:0
ds_read_b128 v[48:51], v10 offset:0
s_waitcnt vmcnt(3)
buffer_load_dwordx4 v[160:163], v6, s[44:47], s15 offen offset:768 nt
s_waitcnt lgkmcnt(3)
v_mfma_f32_16x16x32_bf16 v[52:55], v[36:39], v[20:23], 0
s_waitcnt lgkmcnt(2)
v_mfma_f32_16x16x32_bf16 v[52:55], v[40:43], v[24:27], v[52:55]
s_waitcnt lgkmcnt(1)
v_mfma_f32_16x16x32_bf16 v[52:55], v[44:47], v[28:31], v[52:55]
s_waitcnt lgkmcnt(0)
v_mfma_f32_16x16x32_bf16 v[52:55], v[48:51], v[32:35], v[52:55]
s_add_u32 s12, s13, 0
s_mov_b32 m0, s12
s_add_u32 s12, s11, 131072
s_cbranch_vccz L_t1
s_waitcnt vmcnt(2)
L_t1:
s_waitcnt vmcnt(3)
buffer_load_dwordx4 v2, s[40:43], s12 offen offset:0 nt lds
s_waitcnt vmcnt(25)
ds_read_b128 v[36:39], v7 offset:4096
ds_read_b128 v[40:43], v8 offset:4096
ds_read_b128 v[44:47], v9 offset:4096
ds_read_b128 v[48:51], v10 offset:4096
s_cbranch_vccz L_t2
s_waitcnt vmcnt(2)
L_t2:
s_waitcnt vmcnt(3)
buffer_load_dwordx4 v3, s[40:43], s12 offen offset:1024 nt lds
s_waitcnt lgkmcnt(3)
v_mfma_f32_16x16x32_bf16 v[56:59], v[36:39], v[20:23], 0
s_waitcnt lgkmcnt(2)
v_mfma_f32_16x16x32_bf16 v[56:59], v[40:43], v[24:27], v[56:59]
s_waitcnt lgkmcnt(1)
v_mfma_f32_16x16x32_bf16 v[56:59], v[44:47], v[28:31], v[56:59]
s_waitcnt lgkmcnt(0)
v_mfma_f32_16x16x32_bf16 v[56:59], v[48:51], v[32:35], v[56:59]
s_cbranch_vccz L_t3
s_waitcnt vmcnt(2)
L_t3:
s_waitcnt vmcnt(3)
buffer_load_dwordx4 v4, s[40:43], s12 offen offset:2048 nt lds
s_waitcnt vmcnt(23)
ds_read_b128 v[36:39], v7 offset:8192
ds_read_b128 v[40:43], v8 offset:8192
ds_read_b128 v[44:47], v9 offset:8192
ds_read_b128 v[48:51], v10 offset:8192
s_cbranch_vccz L_t4
s_waitcnt vmcnt(2)
L_t4:
s_waitcnt vmcnt(3)
buffer_load_dwordx4 v5, s[40:43], s12 offen offset:3072 nt lds
s_waitcnt lgkmcnt(3)
v_mfma_f32_16x16x32_bf16 v[60:63], v[36:39], v[20:23], 0
s_waitcnt lgkmcnt(2)
v_mfma_f32_16x16x32_bf16 v[60:63], v[40:43], v[24:27], v[60:63]
s_waitcnt lgkmcnt(1)
v_mfma_f32_16x16x32_bf16 v[60:63], v[44:47], v[28:31], v[60:63]
s_waitcnt lgkmcnt(0)
v_mfma_f32_16x16x32_bf16 v[60:63], v[48:51], v[32:35], v[60:63]
s_add_u32 s12, s13, 4096
s_mov_b32 m0, s12
s_add_u32 s12, s11, 163840
s_cbranch_vccz L_t5
s_waitcnt vmcnt(2)
L_t5:
s_waitcnt vmcnt(3)
buffer_load_dwordx4 v2, s[40:43], s12 offen offset:0 nt lds
s_waitcnt vmcnt(21)
ds_read_b128 v[36:39], v7 offset:12288
ds_read_b128 v[40:43], v8 offset:12288
ds_read_b128 v[44:47], v9 offset:12288
ds_read_b128 v[48:51], v10 offset:12288
s_cbranch_vccz L_t6
s_waitcnt vmcnt(2)
L_t6:
s_waitcnt vmcnt(3)
buffer_load_dwordx4 v3, s[40:43], s12 offen offset:1024 nt lds
s_waitcnt lgkmcnt(3)
v_mfma_f32_16x16x32_bf16 v[64:67], v[36:39], v[20:23], 0
s_waitcnt lgkmcnt(2)
v_mfma_f32_16x16x32_bf16 v[64:67], v[40:43], v[24:27], v[64:67]
s_waitcnt lgkmcnt(1)
v_mfma_f32_16x16x32_bf16 v[64:67], v[44:47], v[28:31], v[64:67]
s_waitcnt lgkmcnt(0)
v_mfma_f32_16x16x32_bf16 v[64:67], v[48:51], v[32:35], v[64:67]
s_cbranch_vccz L_t7
s_waitcnt vmcnt(2)
L_t7:
s_waitcnt vmcnt(3)
buffer_load_dwordx4 v4, s[40:43], s12 offen offset:2048 nt lds
v_max3_f32 v12, v52, v53, v54
v_max_f32 v12, v12, v55
v_max3_f32 v12, v56, v57, v12
v_max3_f32 v12, v58, v59, v12
v_max3_f32 v12, v60, v61, v12
v_max3_f32 v12, v62, v63, v12
s_nop 2
v_max3_f32 v12, v64, v65, v12
v_max3_f32 v12, v66, v67, v12
v_mov_b32 v1, v12
s_nop 1
v_permlane32_swap_b32 v12, v1
v_max_f32 v12, v12, v1
v_mov_b32 v1, v12
s_nop 1
v_permlane16_swap_b32 v12, v1
v_max_f32 v12, v12, v1
v_mul_f32 v1, s37, v12
s_cbranch_vccz L_t8
s_waitcnt vmcnt(2)
L_t8:
s_waitcnt vmcnt(3)
buffer_load_dwordx4 v5, s[40:43], s12 offen offset:3072 nt lds
v_fma_f32 v52, v52, s37, -v1
v_fma_f32 v53, v53, s37, -v1
v_fma_f32 v54, v54, s37, -v1
v_fma_f32 v55, v55, s37, -v1
v_fma_f32 v56, v56, s37, -v1
v_fma_f32 v57, v57, s37, -v1
v_fma_f32 v58, v58, s37, -v1
v_fma_f32 v59, v59, s37, -v1
v_fma_f32 v60, v60, s37, -v1
v_fma_f32 v61, v61, s37, -v1
v_fma_f32 v62, v62, s37, -v1
v_fma_f32 v63, v63, s37, -v1
v_fma_f32 v64, v64, s37, -v1
v_fma_f32 v65, v65, s37, -v1
v_fma_f32 v66, v66, s37, -v1
v_fma_f32 v67, v67, s37, -v1
s_add_u32 s12, s13, 8192
s_mov_b32 m0, s12
s_add_u32 s12, s11, 196608
s_cbranch_vccz L_t9
s_waitcnt vmcnt(2)
L_t9:
s_waitcnt vmcnt(3)
buffer_load_dwordx4 v2, s[40:43], s12 offen offset:0 nt lds
v_exp_f32 v52, v52
v_exp_f32 v53, v53
v_exp_f32 v54, v54
v_exp_f32 v55, v55
v_exp_f32 v56, v56
v_exp_f32 v57, v57
v_exp_f32 v58, v58
v_exp_f32 v59, v59
s_cbranch_vccz L_t10
s_waitcnt vmcnt(2)
L_t10:
s_waitcnt vmcnt(3)
buffer_load_dwordx4 v3, s[40:43], s12 offen offset:1024 nt lds
v_exp_f32 v60, v60
v_exp_f32 v61, v61
v_exp_f32 v62, v62
v_exp_f32 v63, v63
v_exp_f32 v64, v64
v_exp_f32 v65, v65
v_exp_f32 v66, v66
v_exp_f32 v67, v67
s_nop 0
v_add_f32 v13, v52, v53
v_add_f32 v16, v54, v55
v_add_f32 v13, v13, v56
v_add_f32 v16, v16, v57
v_add_f32 v13, v13, v58
v_add_f32 v16, v16, v59
v_add_f32 v13, v13, v60
v_add_f32 v16, v16, v61
v_add_f32 v13, v13, v62
v_add_f32 v16, v16, v63
v_add_f32 v13, v13, v64
v_add_f32 v16, v16, v65
v_add_f32 v13, v13, v66
v_add_f32 v16, v16, v67
v_add_f32 v13, v13, v16
v_cvt_pk_bf16_f32 v52, v52, v53
v_cvt_pk_bf16_f32 v53, v54, v55
v_cvt_pk_bf16_f32 v54, v56, v57
v_cvt_pk_bf16_f32 v55, v58, v59
v_cvt_pk_bf16_f32 v56, v60, v61
v_cvt_pk_bf16_f32 v57, v62, v63
v_cvt_pk_bf16_f32 v58, v64, v65
v_cvt_pk_bf16_f32 v59, v66, v67
s_cbranch_vccz L_t11
s_waitcnt vmcnt(2)
L_t11:
s_waitcnt vmcnt(3)
buffer_load_dwordx4 v4, s[40:43], s12 offen offset:2048 nt lds
s_waitcnt vmcnt(19)
v_perm_b32 v36, v104, v100, s38
v_perm_b32 v37, v112, v108, s38
v_perm_b32 v38, v120, v116, s38
v_perm_b32 v39, v128, v124, s38
v_perm_b32 v40, v104, v100, s39
v_perm_b32 v41, v112, v108, s39
v_perm_b32 v42, v120, v116, s39
v_perm_b32 v43, v128, v124, s39
v_mfma_f32_16x16x32_bf16 v[68:71], v[52:55], v[36:39], 0
v_perm_b32 v44, v105, v101, s38
v_perm_b32 v45, v113, v109, s38
v_perm_b32 v46, v121, v117, s38
v_perm_b32 v47, v129, v125, s38
v_mfma_f32_16x16x32_bf16 v[72:75], v[52:55], v[40:43], 0
v_perm_b32 v48, v105, v101, s39
v_perm_b32 v49, v113, v109, s39
v_perm_b32 v50, v121, v117, s39
v_perm_b32 v51, v129, v125, s39
v_mfma_f32_16x16x32_bf16 v[76:79], v[52:55], v[44:47], 0
s_cbranch_vccz L_t12
s_waitcnt vmcnt(2)
L_t12:
s_waitcnt vmcnt(3)
buffer_load_dwordx4 v5, s[40:43], s12 offen offset:3072 nt lds
v_perm_b32 v36, v106, v102, s38
v_perm_b32 v37, v114, v110, s38
v_perm_b32 v38, v122, v118, s38
v_perm_b32 v39, v130, v126, s38
v_mfma_f32_16x16x32_bf16 v[80:83], v[52:55], v[48:51], 0
v_perm_b32 v40, v106, v102, s39
v_perm_b32 v41, v114, v110, s39
v_perm_b32 v42, v122, v118, s39
v_perm_b32 v43, v130, v126, s39
v_mfma_f32_16x16x32_bf16 v[84:87], v[52:55], v[36:39], 0
v_perm_b32 v44, v107, v103, s38
v_perm_b32 v45, v115, v111, s38
v_perm_b32 v46, v123, v119, s38
v_perm_b32 v47, v131, v127, s38
v_mfma_f32_16x16x32_bf16 v[88:91], v[52:55], v[40:43], 0
s_add_u32 s12, s13, 12288
s_mov_b32 m0, s12
s_add_u32 s12, s11, 229376
s_cbranch_vccz L_t13
s_waitcnt vmcnt(2)
L_t13:
s_waitcnt vmcnt(3)
buffer_load_dwordx4 v2, s[40:43], s12 offen offset:0 nt lds
v_perm_b32 v48, v107, v103, s39
v_perm_b32 v49, v115, v111, s39
v_perm_b32 v50, v123, v119, s39
v_perm_b32 v51, v131, v127, s39
v_mfma_f32_16x16x32_bf16 v[92:95], v[52:55], v[44:47], 0
s_nop 1
v_mfma_f32_16x16x32_bf16 v[96:99], v[52:55], v[48:51], 0
s_waitcnt vmcnt(13)
v_perm_b32 v36, v136, v132, s38
v_perm_b32 v37, v144, v140, s38
v_perm_b32 v38, v152, v148, s38
v_perm_b32 v39, v160, v156, s38
v_perm_b32 v40, v136, v132, s39
v_perm_b32 v41, v144, v140, s39
v_perm_b32 v42, v152, v148, s39
v_perm_b32 v43, v160, v156, s39
v_mfma_f32_16x16x32_bf16 v[68:71], v[56:59], v[36:39], v[68:71]
v_perm_b32 v44, v137, v133, s38
v_perm_b32 v45, v145, v141, s38
v_perm_b32 v46, v153, v149, s38
v_perm_b32 v47, v161, v157, s38
v_mfma_f32_16x16x32_bf16 v[72:75], v[56:59], v[40:43], v[72:75]
v_perm_b32 v48, v137, v133, s39
v_perm_b32 v49, v145, v141, s39
v_perm_b32 v50, v153, v149, s39
v_perm_b32 v51, v161, v157, s39
v_mfma_f32_16x16x32_bf16 v[76:79], v[56:59], v[44:47], v[76:79]
s_cbranch_vccz L_t14
s_waitcnt vmcnt(2)
L_t14:
s_waitcnt vmcnt(3)
buffer_load_dwordx4 v3, s[40:43], s12 offen offset:1024 nt lds
v_perm_b32 v36, v138, v134, s38
v_perm_b32 v37, v146, v142, s38
v_perm_b32 v38, v154, v150, s38
v_perm_b32 v39, v162, v158, s38
v_mfma_f32_16x16x32_bf16 v[80:83], v[56:59], v[48:51], v[80:83]
v_perm_b32 v40, v138, v134, s39
v_perm_b32 v41, v146, v142, s39
v_perm_b32 v42, v154, v150, s39
v_perm_b32 v43, v162, v158, s39
v_mfma_f32_16x16x32_bf16 v[84:87], v[56:59], v[36:39], v[84:87]
v_perm_b32 v44, v139, v135, s38
v_perm_b32 v45, v147, v143, s38
v_perm_b32 v46, v155, v151, s38
v_perm_b32 v47, v163, v159, s38
v_mfma_f32_16x16x32_bf16 v[88:91], v[56:59], v[40:43], v[88:91]
s_cbranch_vccz L_t15
s_waitcnt vmcnt(2)
L_t15:
s_waitcnt vmcnt(3)
buffer_load_dwordx4 v4, s[40:43], s12 offen offset:2048 nt lds
v_perm_b32 v48, v139, v135, s39
v_perm_b32 v49, v147, v143, s39
v_perm_b32 v50, v155, v151, s39
v_perm_b32 v51, v163, v159, s39
v_mfma_f32_16x16x32_bf16 v[92:95], v[56:59], v[44:47], v[92:95]
s_nop 1
v_mfma_f32_16x16x32_bf16 v[96:99], v[56:59], v[48:51], v[96:99]
s_cbranch_vccz L_t16
s_waitcnt vmcnt(2)
L_t16:
s_waitcnt vmcnt(3)
buffer_load_dwordx4 v5, s[40:43], s12 offen offset:3072 nt lds
s_add_u32 s15, s11, 131072
s_cbranch_vccz L_t17
s_waitcnt vmcnt(2)
L_t17:
s_waitcnt vmcnt(3)
buffer_load_dwordx4 v[100:103], v6, s[44:47], s15 offen offset:0 nt
s_waitcnt vmcnt(13)
ds_read_b128 v[36:39], v7 offset:0
ds_read_b128 v[40:43], v8 offset:0
ds_read_b128 v[44:47], v9 offset:0
ds_read_b128 v[48:51], v10 offset:0
s_waitcnt lgkmcnt(3)
v_mfma_f32_16x16x32_bf16 v[52:55], v[36:39], v[20:23], 0
s_waitcnt lgkmcnt(2)
v_mfma_f32_16x16x32_bf16 v[52:55], v[40:43], v[24:27], v[52:55]
s_waitcnt lgkmcnt(1)
v_mfma_f32_16x16x32_bf16 v[52:55], v[44:47], v[28:31], v[52:55]
s_waitcnt lgkmcnt(0)
v_mfma_f32_16x16x32_bf16 v[52:55], v[48:51], v[32:35], v[52:55]
s_cbranch_vccz L_t18
s_waitcnt vmcnt(2)
L_t18:
s_waitcnt vmcnt(3)
buffer_load_dwordx4 v[104:107], v6, s[44:47], s15 offen offset:256 nt
s_waitcnt vmcnt(10)
ds_read_b128 v[36:39], v7 offset:4096
ds_read_b128 v[40:43], v8 offset:4096
ds_read_b128 v[44:47], v9 offset:4096
ds_read_b128 v[48:51], v10 offset:4096
s_waitcnt lgkmcnt(3)
v_mfma_f32_16x16x32_bf16 v[56:59], v[36:39], v[20:23], 0
s_waitcnt lgkmcnt(2)
v_mfma_f32_16x16x32_bf16 v[56:59], v[40:43], v[24:27], v[56:59]
s_waitcnt lgkmcnt(1)
v_mfma_f32_16x16x32_bf16 v[56:59], v[44:47], v[28:31], v[56:59]
s_waitcnt lgkmcnt(0)
v_mfma_f32_16x16x32_bf16 v[56:59], v[48:51], v[32:35], v[56:59]
s_cbranch_vccz L_t19
s_waitcnt vmcnt(2)
L_t19:
s_waitcnt vmcnt(3)
buffer_load_dwordx4 v[108:111], v6, s[44:47], s15 offen offset:512 nt
s_waitcnt vmcnt(7)
ds_read_b128 v[36:39], v7 offset:8192
ds_read_b128 v[40:43], v8 offset:8192
ds_read_b128 v[44:47], v9 offset:8192
ds_read_b128 v[48:51], v10 offset:8192
s_waitcnt lgkmcnt(3)
v_mfma_f32_16x16x32_bf16 v[60:63], v[36:39], v[20:23], 0
s_waitcnt lgkmcnt(2)
v_mfma_f32_16x16x32_bf16 v[60:63], v[40:43], v[24:27], v[60:63]
s_waitcnt lgkmcnt(1)
v_mfma_f32_16x16x32_bf16 v[60:63], v[44:47], v[28:31], v[60:63]
s_waitcnt lgkmcnt(0)
v_mfma_f32_16x16x32_bf16 v[60:63], v[48:51], v[32:35], v[60:63]
s_cbranch_vccz L_t20
s_waitcnt vmcnt(2)
L_t20:
s_waitcnt vmcnt(3)
buffer_load_dwordx4 v[112:115], v6, s[44:47], s15 offen offset:768 nt
s_waitcnt vmcnt(4)
ds_read_b128 v[36:39], v7 offset:12288
ds_read_b128 v[40:43], v8 offset:12288
ds_read_b128 v[44:47], v9 offset:12288
ds_read_b128 v[48:51], v10 offset:12288
s_waitcnt lgkmcnt(3)
v_mfma_f32_16x16x32_bf16 v[64:67], v[36:39], v[20:23], 0
s_waitcnt lgkmcnt(2)
v_mfma_f32_16x16x32_bf16 v[64:67], v[40:43], v[24:27], v[64:67]
s_waitcnt lgkmcnt(1)
v_mfma_f32_16x16x32_bf16 v[64:67], v[44:47], v[28:31], v[64:67]
s_waitcnt lgkmcnt(0)
v_mfma_f32_16x16x32_bf16 v[64:67], v[48:51], v[32:35], v[64:67]
v_lshlrev_b32 v18, 5, v0
s_lshl_b32 s8, s36, 2
s_add_u32 s8, s8, 152832
v_add_u32 v18, s8, v18
s_add_u32 s15, s11, 163840
s_cbranch_vccz L_t21
s_waitcnt vmcnt(2)
L_t21:
s_waitcnt vmcnt(3)
buffer_load_dwordx4 v[116:119], v6, s[44:47], s15 offen offset:0 nt
v_max3_f32 v17, v52, v53, v12
v_max3_f32 v17, v54, v55, v17
v_max3_f32 v17, v56, v57, v17
v_max3_f32 v17, v58, v59, v17
v_max3_f32 v17, v60, v61, v17
v_max3_f32 v17, v62, v63, v17
s_nop 2
v_max3_f32 v17, v64, v65, v17
v_max3_f32 v17, v66, v67, v17
v_mov_b32 v1, v17
s_nop 1
v_permlane32_swap_b32 v17, v1
v_max_f32 v17, v17, v1
v_mov_b32 v1, v17
s_nop 1
v_permlane16_swap_b32 v17, v1
v_max_f32 v17, v17, v1
s_mov_b64 exec, 0xf
ds_write_b32 v18, v17
s_mov_b64 exec, -1
v_and_b32 v1, 3, v0
v_lshlrev_b32 v1, 5, v1
v_add_u32 v1, 152832, v1
s_cbranch_vccz L_t22
s_waitcnt vmcnt(2)
L_t22:
s_waitcnt vmcnt(3)
buffer_load_dwordx4 v[120:123], v6, s[44:47], s15 offen offset:256 nt
s_cbranch_vccz L_t23
s_waitcnt vmcnt(2)
L_t23:
s_waitcnt vmcnt(3)
buffer_load_dwordx4 v[124:127], v6, s[44:47], s15 offen offset:512 nt
s_waitcnt lgkmcnt(0)
s_barrier
ds_read_b128 v[36:39], v1
ds_read_b128 v[40:43], v1 offset:16
v_lshlrev_b32 v9, 2, v0
v_add_u32 v8, 152960, v9
v_add_u32 v9, s14, v9
v_lshlrev_b32 v20, 1, v14
v_xor_b32 v20, v20, v15
v_lshlrev_b32 v20, 4, v20
v_lshl_add_u32 v20, v14, 8, v20
v_xor_b32 v21, 128, v20
v_and_b32 v24, 3, v0
v_lshlrev_b32 v24, 4, v24
v_lshl_add_u32 v24, v14, 6, v24
v_add_u32 v24, 154336, v24
s_and_b32 s8, s36, 1
s_lshl_b32 s8, s8, 3
s_lshr_b32 s9, s36, 1
s_lshl_b32 s9, s9, 8
s_add_u32 s8, s8, s9
v_add_u32 v23, s8, v24
s_cbranch_vccz L_t24
s_waitcnt vmcnt(2)
L_t24:
s_waitcnt vmcnt(3)
buffer_load_dwordx4 v[128:131], v6, s[44:47], s15 offen offset:768 nt
s_waitcnt lgkmcnt(0)
v_max3_f32 v17, v36, v37, v38
v_max3_f32 v17, v39, v40, v17
v_max3_f32 v17, v41, v42, v17
v_max_f32 v17, v43, v17
v_sub_f32 v18, v12, v17
v_mul_f32 v18, s37, v18
v_exp_f32 v18, v18
v_mul_f32 v1, s37, v17
s_nop 0
v_mul_f32 v13, v13, v18
v_readlane_b32 s16, v18, 0
v_readlane_b32 s17, v18, 1
v_readlane_b32 s18, v18, 2
v_readlane_b32 s19, v18, 3
v_fma_f32 v52, v52, s37, -v1
v_fma_f32 v53, v53, s37, -v1
v_fma_f32 v54, v54, s37, -v1
v_fma_f32 v55, v55, s37, -v1
v_fma_f32 v56, v56, s37, -v1
v_fma_f32 v57, v57, s37, -v1
v_fma_f32 v58, v58, s37, -v1
v_fma_f32 v59, v59, s37, -v1
v_fma_f32 v60, v60, s37, -v1
v_fma_f32 v61, v61, s37, -v1
v_fma_f32 v62, v62, s37, -v1
v_fma_f32 v63, v63, s37, -v1
v_fma_f32 v64, v64, s37, -v1
v_fma_f32 v65, v65, s37, -v1
v_fma_f32 v66, v66, s37, -v1
v_fma_f32 v67, v67, s37, -v1
s_lshl_b32 s15, s36, 12
s_add_u32 s15, s15, 32768
s_mov_b32 m0, s15
s_add_u32 s15, s11, 196608
s_waitcnt vmcnt(5)
buffer_load_dwordx4 v20, s[44:47], s15 offen offset:0 nt lds
v_exp_f32 v52, v52
v_exp_f32 v53, v53
v_exp_f32 v54, v54
v_exp_f32 v55, v55
v_exp_f32 v56, v56
v_exp_f32 v57, v57
v_exp_f32 v58, v58
v_exp_f32 v59, v59
s_waitcnt vmcnt(5)
buffer_load_dwordx4 v21, s[44:47], s15 offen offset:1024 nt lds
v_exp_f32 v60, v60
v_exp_f32 v61, v61
v_exp_f32 v62, v62
v_exp_f32 v63, v63
v_exp_f32 v64, v64
v_exp_f32 v65, v65
v_exp_f32 v66, v66
v_exp_f32 v67, v67
s_nop 0
v_add_f32 v16, v52, v53
v_add_f32 v13, v13, v54
v_add_f32 v16, v16, v55
v_add_f32 v13, v13, v56
v_add_f32 v16, v16, v57
v_add_f32 v13, v13, v58
v_add_f32 v16, v16, v59
v_add_f32 v13, v13, v60
v_add_f32 v16, v16, v61
v_add_f32 v13, v13, v62
v_add_f32 v16, v16, v63
v_add_f32 v13, v13, v64
v_add_f32 v16, v16, v65
v_add_f32 v13, v13, v66
v_add_f32 v16, v16, v67
v_add_f32 v13, v13, v16
v_cvt_pk_bf16_f32 v52, v52, v53
v_cvt_pk_bf16_f32 v53, v54, v55
v_cvt_pk_bf16_f32 v54, v56, v57
v_cvt_pk_bf16_f32 v55, v58, v59
v_cvt_pk_bf16_f32 v56, v60, v61
v_cvt_pk_bf16_f32 v57, v62, v63
v_cvt_pk_bf16_f32 v58, v64, v65
v_cvt_pk_bf16_f32 v59, v66, v67
v_mov_b32 v16, v13
s_nop 1
v_permlane32_swap_b32 v13, v16
v_add_f32 v13, v13, v16
v_mov_b32 v16, v13
s_nop 1
v_permlane16_swap_b32 v13, v16
v_add_f32 v13, v13, v16
s_mov_b64 exec, 0xf
ds_write_b32 v9, v13 offset:2304
ds_write_b32 v8, v1
s_mov_b32 exec_lo, 0x000f000f
s_mov_b32 exec_hi, 0x000f000f
ds_write_b64 v23, v[56:57]
ds_write_b64 v23, v[58:59] offset:1024
s_mov_b64 exec, -1
s_waitcnt vmcnt(5)
buffer_load_dwordx4 v20, s[44:47], s15 offen offset:2048 nt lds
s_waitcnt lgkmcnt(0)
s_barrier
v_mul_f32 v68, s16, v68
v_mul_f32 v69, s17, v69
v_mul_f32 v70, s18, v70
v_mul_f32 v71, s19, v71
v_mul_f32 v72, s16, v72
v_mul_f32 v73, s17, v73
v_mul_f32 v74, s18, v74
v_mul_f32 v75, s19, v75
v_mul_f32 v76, s16, v76
v_mul_f32 v77, s17, v77
v_mul_f32 v78, s18, v78
v_mul_f32 v79, s19, v79
v_mul_f32 v80, s16, v80
v_mul_f32 v81, s17, v81
v_mul_f32 v82, s18, v82
v_mul_f32 v83, s19, v83
s_waitcnt vmcnt(5)
buffer_load_dwordx4 v21, s[44:47], s15 offen offset:3072 nt lds
v_mul_f32 v84, s16, v84
v_mul_f32 v85, s17, v85
v_mul_f32 v86, s18, v86
v_mul_f32 v87, s19, v87
v_mul_f32 v88, s16, v88
v_mul_f32 v89, s17, v89
v_mul_f32 v90, s18, v90
v_mul_f32 v91, s19, v91
v_mul_f32 v92, s16, v92
v_mul_f32 v93, s17, v93
v_mul_f32 v94, s18, v94
v_mul_f32 v95, s19, v95
v_mul_f32 v96, s16, v96
v_mul_f32 v97, s17, v97
v_mul_f32 v98, s18, v98
v_mul_f32 v99, s19, v99
s_lshl_b32 s15, s36, 12
s_add_u32 s15, s15, 65536
s_mov_b32 m0, s15
s_add_u32 s15, s11, 229376
s_waitcnt vmcnt(5)
buffer_load_dwordx4 v20, s[44:47], s15 offen offset:0 nt lds
s_lshl_b32 s8, s31, 9
s_lshl_b32 s9, s34, 5
s_add_u32 s8, s8, s9
s_lshl2_add_u32 s8, s36, s8
s_lshl_b32 s8, s8, 10
s_lshl_b32 s9, s33, 8
s_add_u32 s63, s8, s9
v_lshlrev_b32 v18, 1, v14
v_xor_b32 v18, v18, v15
v_lshlrev_b32 v18, 4, v18
v_lshl_add_u32 v18, v14, 17, v18
v_xor_b32 v19, 128, v18
s_lshl_b32 s21, s36, 12
ds_read_b128 v[132:135], v24 offset:0
ds_read_b128 v[136:139], v24 offset:256
ds_read_b128 v[140:143], v24 offset:512
ds_read_b128 v[144:147], v24 offset:768
ds_read_b128 v[148:151], v24 offset:1024
ds_read_b128 v[152:155], v24 offset:1280
ds_read_b128 v[156:159], v24 offset:1536
ds_read_b128 v[160:163], v24 offset:1792
v_mov_b32 v10, 154320
ds_read_b32 v2, v10
ds_read_b32 v10, v10 offset:4
s_waitcnt lgkmcnt(0)
v_readfirstlane_b32 s62, v2
v_lshrrev_b32 v2, 2, v0
v_mul_u32_u24 v3, 2176, v2
v_and_b32 v4, 3, v0
v_lshl_add_u32 v3, v4, 4, v3
v_lshlrev_b32 v2, 4, v2
v_add_u32 v2, 152976, v2
s_mul_i32 s8, s35, 34816
s_add_u32 s8, s8, 524288
s_lshl_b32 s9, s34, 9
s_lshl_b32 s10, s36, 6
s_add_u32 s9, s9, s10
s_add_u32 s9, s9, s8
s_mul_i32 s10, s32, 2176
s_add_u32 s10, s10, s8
s_lshl_b32 s8, s36, 8
s_add_u32 s10, s10, s8
v_and_b32 v5, 7, v0
v_mul_u32_u24 v5, 288, v5
v_bfe_u32 v7, v0, 3, 1
v_lshl_add_u32 v5, v7, 4, v5
v_mul_u32_u24 v7, 5184, v14
v_add_u32 v5, v5, v7
s_lshl_b32 s8, s36, 5
s_add_u32 s8, s8, 131072
v_add_u32 v5, s8, v5
v_lshlrev_b32 v7, 4, v15
v_mul_u32_u24 v8, 272, v14
v_lshl_add_u32 v8, v4, 3, v8
s_lshl_b32 s8, s36, 5
s_add_u32 s8, s8, 153232
v_add_u32 v8, s8, v8
v_mul_u32_u24 v9, 272, v4
v_lshl_add_u32 v9, v14, 4, v9
v_add_u32 v9, 153232, v9
v_bfe_u32 v12, v0, 2, 2
v_and_b32 v13, 1, v14
v_lshl_add_u32 v13, v13, 2, v12
v_lshlrev_b32 v13, 1, v13
v_lshrrev_b32 v16, 1, v4
s_lshl_b32 s8, s36, 1
v_add_u32 v16, s8, v16
v_xor_b32 v13, v13, v16
v_lshl_add_u32 v12, v14, 3, v12
v_lshlrev_b32 v12, 8, v12
v_lshl_add_u32 v12, v13, 4, v12
v_and_b32 v13, 1, v0
v_lshl_add_u32 v12, v13, 3, v12
s_mov_b32 s8, s31
s_lshl2_add_u32 s12, s30, s33
s_lshl3_add_u32 s12, s12, s8
s_lshl2_add_u32 s12, s12, s34
s_lshl3_add_u32 s12, s12, s36
s_lshl_b32 s12, s12, 8
s_add_u32 s12, s12, 1179648
s_waitcnt vmcnt(5)
buffer_load_dwordx4 v21, s[44:47], s15 offen offset:1024 nt lds
s_waitcnt vmcnt(6)
v_perm_b32 v36, v104, v100, s38
v_perm_b32 v37, v112, v108, s38
v_perm_b32 v38, v120, v116, s38
v_perm_b32 v39, v128, v124, s38
v_perm_b32 v40, v104, v100, s39
v_perm_b32 v41, v112, v108, s39
v_perm_b32 v42, v120, v116, s39
v_perm_b32 v43, v128, v124, s39
v_mfma_f32_16x16x32_bf16 v[68:71], v[52:55], v[36:39], v[68:71]
v_perm_b32 v44, v105, v101, s38
v_perm_b32 v45, v113, v109, s38
v_perm_b32 v46, v121, v117, s38
v_perm_b32 v47, v129, v125, s38
v_mfma_f32_16x16x32_bf16 v[72:75], v[52:55], v[40:43], v[72:75]
v_perm_b32 v48, v105, v101, s39
v_perm_b32 v49, v113, v109, s39
v_perm_b32 v50, v121, v117, s39
v_perm_b32 v51, v129, v125, s39
v_mfma_f32_16x16x32_bf16 v[76:79], v[52:55], v[44:47], v[76:79]
s_waitcnt vmcnt(5)
buffer_load_dwordx4 v20, s[44:47], s15 offen offset:2048 nt lds
v_perm_b32 v36, v106, v102, s38
v_perm_b32 v37, v114, v110, s38
v_perm_b32 v38, v122, v118, s38
v_perm_b32 v39, v130, v126, s38
v_mfma_f32_16x16x32_bf16 v[80:83], v[52:55], v[48:51], v[80:83]
v_perm_b32 v40, v106, v102, s39
v_perm_b32 v41, v114, v110, s39
v_perm_b32 v42, v122, v118, s39
v_perm_b32 v43, v130, v126, s39
v_mfma_f32_16x16x32_bf16 v[84:87], v[52:55], v[36:39], v[84:87]
v_perm_b32 v44, v107, v103, s38
v_perm_b32 v45, v115, v111, s38
v_perm_b32 v46, v123, v119, s38
v_perm_b32 v47, v131, v127, s38
v_mfma_f32_16x16x32_bf16 v[88:91], v[52:55], v[40:43], v[88:91]
s_waitcnt vmcnt(5)
buffer_load_dwordx4 v21, s[44:47], s15 offen offset:3072 nt lds
v_perm_b32 v48, v107, v103, s39
v_perm_b32 v49, v115, v111, s39
v_perm_b32 v50, v123, v119, s39
v_perm_b32 v51, v131, v127, s39
v_mfma_f32_16x16x32_bf16 v[92:95], v[52:55], v[44:47], v[92:95]
s_nop 1
v_mfma_f32_16x16x32_bf16 v[96:99], v[52:55], v[48:51], v[96:99]
s_mov_b64 exec, 0xffff
ds_write_b128 v11, v[68:71] offset:0
ds_write_b128 v11, v[72:75] offset:288
ds_write_b128 v11, v[76:79] offset:576
ds_write_b128 v11, v[80:83] offset:864
ds_write_b128 v11, v[84:87] offset:1152
ds_write_b128 v11, v[88:91] offset:1440
ds_write_b128 v11, v[92:95] offset:1728
ds_write_b128 v11, v[96:99] offset:2016
s_mov_b64 exec, -1
v_lshlrev_b32 v22, 10, v14
v_sub_u32 v22, v12, v22
v_add_u32 v22, 32768, v22
s_waitcnt lgkmcnt(0)
s_barrier
ds_read_b128 v[68:71], v5
ds_read_b128 v[72:75], v5 offset:2592
s_waitcnt lgkmcnt(0)
v_add_f32 v68, v68, v72
v_add_f32 v69, v69, v73
v_add_f32 v70, v70, v74
v_add_f32 v71, v71, v75
v_mov_b32 v72, v68
v_mov_b32 v73, v69
v_mov_b32 v74, v70
v_mov_b32 v75, v71
v_permlane32_swap_b32 v68, v72
v_permlane32_swap_b32 v69, v73
v_permlane32_swap_b32 v70, v74
v_permlane32_swap_b32 v71, v75
v_add_f32 v68, v68, v72
v_add_f32 v69, v69, v73
v_add_f32 v70, v70, v74
v_add_f32 v71, v71, v75
v_mov_b32 v72, v68
v_mov_b32 v73, v69
v_mov_b32 v74, v70
v_mov_b32 v75, v71
v_permlane16_swap_b32 v68, v72
v_permlane16_swap_b32 v69, v73
v_permlane16_swap_b32 v70, v74
v_permlane16_swap_b32 v71, v75
v_add_f32 v68, v68, v72
v_add_f32 v69, v69, v73
v_add_f32 v70, v70, v74
v_add_f32 v71, v71, v75
s_mov_b32 m0, s21
s_nop 0
buffer_load_dwordx4 v18, s[4:7], s63 offen offset:0 nt lds
s_waitcnt vmcnt(5)
s_barrier
ds_read_b64_tr_b16 v[100:101], v22 offset:0
ds_read_b64_tr_b16 v[102:103], v22 offset:4096
ds_read_b64_tr_b16 v[104:105], v22 offset:8192
ds_read_b64_tr_b16 v[106:107], v22 offset:12288
ds_read_b64_tr_b16 v[108:109], v22 offset:16384
ds_read_b64_tr_b16 v[110:111], v22 offset:20480
ds_read_b64_tr_b16 v[112:113], v22 offset:24576
ds_read_b64_tr_b16 v[114:115], v22 offset:28672
s_waitcnt lgkmcnt(6)
v_mfma_f32_16x16x32_bf16 v[68:71], v[132:135], v[100:103], v[68:71]
s_waitcnt lgkmcnt(4)
v_mfma_f32_16x16x32_bf16 v[68:71], v[136:139], v[104:107], v[68:71]
s_waitcnt lgkmcnt(2)
v_mfma_f32_16x16x32_bf16 v[68:71], v[140:143], v[108:111], v[68:71]
s_waitcnt lgkmcnt(0)
v_mfma_f32_16x16x32_bf16 v[68:71], v[144:147], v[112:115], v[68:71]
buffer_load_dwordx4 v18, s[4:7], s63 offen offset:1024 nt lds
buffer_load_dwordx4 v19, s[4:7], s63 offen offset:2048 nt lds
buffer_load_dwordx4 v19, s[4:7], s63 offen offset:3072 nt lds
s_waitcnt vmcnt(4)
s_barrier
ds_read_b64_tr_b16 v[100:101], v22 offset:32768
ds_read_b64_tr_b16 v[102:103], v22 offset:36864
ds_read_b64_tr_b16 v[104:105], v22 offset:40960
ds_read_b64_tr_b16 v[106:107], v22 offset:45056
ds_read_b64_tr_b16 v[108:109], v22 offset:49152
ds_read_b64_tr_b16 v[110:111], v22 offset:53248
ds_read_b64_tr_b16 v[112:113], v22 offset:57344
ds_read_b64_tr_b16 v[114:115], v22 offset:61440
s_waitcnt lgkmcnt(6)
v_mfma_f32_16x16x32_bf16 v[68:71], v[148:151], v[100:103], v[68:71]
s_waitcnt lgkmcnt(4)
v_mfma_f32_16x16x32_bf16 v[68:71], v[152:155], v[104:107], v[68:71]
s_waitcnt lgkmcnt(2)
v_mfma_f32_16x16x32_bf16 v[68:71], v[156:159], v[108:111], v[68:71]
s_waitcnt lgkmcnt(0)
v_mfma_f32_16x16x32_bf16 v[68:71], v[160:163], v[112:115], v[68:71]
s_mov_b64 exec, 0xffff
s_nop 6
v_bfi_b32 v100, s3, v10, v68
v_bfi_b32 v101, s3, v10, v69
v_bfi_b32 v102, s3, v10, v70
v_bfi_b32 v103, s3, v10, v71
s_cmp_eq_u32 s62, 0
s_cbranch_scc1 L_l25
buffer_store_dwordx4 v[100:103], v7, s[56:59], s10 offen
L_m25:
s_mov_b64 exec, -1
s_mov_b32 s15, 0
s_waitcnt vmcnt(0)
L_p1:
buffer_load_dwordx4 v[36:39], v3, s[56:59], s9 offen sc1
ds_read_b128 v[40:43], v2
s_add_u32 s15, s15, 1
s_waitcnt vmcnt(0) lgkmcnt(0)
v_xor_b32 v1, v36, v10
v_bitop3_b32 v1, v1, v37, v10 bitop3:0xf6
v_bitop3_b32 v1, v1, v38, v10 bitop3:0xf6
v_bitop3_b32 v1, v1, v39, v10 bitop3:0xf6
v_bitop3_b32 v1, v1, v40, v10 bitop3:0xf6
v_bitop3_b32 v1, v1, v41, v10 bitop3:0xf6
v_bitop3_b32 v1, v1, v42, v10 bitop3:0xf6
v_bitop3_b32 v1, v1, v43, v10 bitop3:0xf6
v_and_b32 v1, s3, v1
v_cmp_ne_u32 vcc, 0, v1
s_cbranch_vccz L_p1_ok
s_mov_b64 exec, vcc
s_sleep 1
s_cmp_lt_u32 s15, 200000
s_cbranch_scc1 L_p1
L_p1_ok:
s_mov_b64 exec, -1
v_bfi_b32 v36, s3, 0, v36
v_bfi_b32 v37, s3, 0, v37
v_bfi_b32 v38, s3, 0, v38
v_bfi_b32 v39, s3, 0, v39
v_bfi_b32 v44, s3, 0, v40
v_bfi_b32 v45, s3, 0, v41
v_bfi_b32 v46, s3, 0, v42
v_bfi_b32 v47, s3, 0, v43
v_mul_f32 v104, v36, v44
v_mul_f32 v105, v37, v45
v_mul_f32 v106, v38, v46
v_mul_f32 v107, v39, v47
v_add_f32_dpp v104, v104, v104 row_ror:4 row_mask:0xf bank_mask:0xf
v_add_f32_dpp v105, v105, v105 row_ror:4 row_mask:0xf bank_mask:0xf
v_add_f32_dpp v106, v106, v106 row_ror:4 row_mask:0xf bank_mask:0xf
v_add_f32_dpp v107, v107, v107 row_ror:4 row_mask:0xf bank_mask:0xf
v_add_f32_dpp v104, v104, v104 row_ror:8 row_mask:0xf bank_mask:0xf
v_add_f32_dpp v105, v105, v105 row_ror:8 row_mask:0xf bank_mask:0xf
v_add_f32_dpp v106, v106, v106 row_ror:8 row_mask:0xf bank_mask:0xf
v_add_f32_dpp v107, v107, v107 row_ror:8 row_mask:0xf bank_mask:0xf
v_cvt_pk_bf16_f32 v16, v104, v105
v_cvt_pk_bf16_f32 v17, v106, v107
s_mov_b32 exec_lo, 0x000f000f
s_mov_b32 exec_hi, 0x000f000f
ds_write_b64 v8, v[16:17]
s_mov_b64 exec, -1
s_waitcnt vmcnt(0) lgkmcnt(0)
s_barrier
ds_read_b128 v[52:55], v9 offset:0
ds_read_b64_tr_b16 v[20:21], v12 offset:0
ds_read_b64_tr_b16 v[22:23], v12 offset:1024
ds_read_b128 v[56:59], v9 offset:64
ds_read_b64_tr_b16 v[24:25], v12 offset:8192
ds_read_b64_tr_b16 v[26:27], v12 offset:9216
ds_read_b128 v[60:63], v9 offset:128
ds_read_b64_tr_b16 v[28:29], v12 offset:16384
ds_read_b64_tr_b16 v[30:31], v12 offset:17408
ds_read_b128 v[64:67], v9 offset:192
ds_read_b64_tr_b16 v[32:33], v12 offset:24576
ds_read_b64_tr_b16 v[34:35], v12 offset:25600
s_waitcnt lgkmcnt(9)
v_mfma_f32_16x16x32_bf16 v[68:71], v[52:55], v[20:23], 0
s_waitcnt lgkmcnt(6)
v_mfma_f32_16x16x32_bf16 v[68:71], v[56:59], v[24:27], v[68:71]
s_waitcnt lgkmcnt(3)
v_mfma_f32_16x16x32_bf16 v[68:71], v[60:63], v[28:31], v[68:71]
s_waitcnt lgkmcnt(0)
v_mfma_f32_16x16x32_bf16 v[68:71], v[64:67], v[32:35], v[68:71]
s_mov_b64 exec, 0xffff
s_nop 6
v_bfi_b32 v68, s3, v10, v68
v_bfi_b32 v69, s3, v10, v69
v_bfi_b32 v70, s3, v10, v70
v_bfi_b32 v71, s3, v10, v71
buffer_store_dwordx4 v[68:71], v7, s[56:59], s12 offen sc1
s_endpgm
L_svc1:
s_load_dwordx2 s[44:45], s[0:1], s8 offset:16
s_load_dwordx2 s[4:5], s[0:1], s8 offset:32
s_mov_b32 s46, 0x2000000
s_mov_b32 s47, s51
s_mov_b32 s6, s50
s_mov_b32 s7, s51
s_lshl3_add_u32 s11, s33, s31
s_lshl2_add_u32 s11, s11, s34
s_lshl_b32 s11, s11, 18
s_lshl_b32 s12, s31, 19
v_and_b32 v20, 63, v0
v_lshlrev_b32 v21, 16, v20
v_lshlrev_b32 v20, 15, v20
s_waitcnt lgkmcnt(0)
s_mov_b64 exec, 1
buffer_load_dword v22, v20, s[44:47], s11 offen nt
s_mov_b64 exec, 1
buffer_load_dword v23, v21, s[4:7], s12 offen nt
s_mov_b64 exec, -1
v_and_b32 v0, 63, v0
s_lshl2_add_u32 s32, s33, s34
s_lshl3_add_u32 s35, s30, s31
s_mov_b32 s58, 0x3c0000
s_mov_b32 s59, s51
s_mov_b32 s3, 0x3ff
s_getreg_b32 s62, hwreg(HW_REG_XCC_ID, 0, 4)
s_mul_i32 s18, s35, 2048
s_add_u32 s18, s18, 1704192
s_mul_i32 s20, s32, 128
s_add_u32 s20, s20, s18
v_mul_u32_u24 v12, 128, v0
v_lshrrev_b32 v6, 5, v0
v_and_b32 v7, 31, v0
v_lshlrev_b32 v4, 13, v6
v_lshl_add_u32 v4, v7, 4, v4
s_lshl_b32 s16, s35, 15
s_lshl_b32 s9, s34, 11
s_add_u32 s9, s9, s16
s_lshl_b32 s10, s33, 9
s_add_u32 s9, s9, s10
s_add_u32 s8, s9, 16384
v_and_b32 v3, 1, v0
v_mul_u32_u24 v3, 1152, v3
v_lshrrev_b32 v8, 1, v7
v_lshl_add_u32 v3, v8, 4, v3
v_lshl_add_u32 v3, v6, 2, v3
v_add_u32 v3, 131072, v3
v_lshlrev_b32 v5, 11, v6
v_lshl_add_u32 v5, v7, 4, v5
s_lshl_b32 s10, s33, 13
s_add_u32 s10, s10, s16
s_add_u32 s11, s10, 4096
v_lshlrev_b32 v2, 8, v6
v_lshl_add_u32 v2, v7, 3, v2
v_add_u32 v2, 151808, v2
s_waitcnt lgkmcnt(0)
s_add_u32 s60, s60, 1
v_mov_b32 v10, s60
s_lshl4_add_u32 s63, s60, s62
v_mov_b32 v13, s63
s_mov_b64 exec, 1
buffer_store_dword v13, v12, s[56:59], s20 offen sc1
s_mov_b64 exec, -1
s_waitcnt vmcnt(0)
s_mov_b64 exec, 0xffff
buffer_load_dword v13, v12, s[56:59], s18 offen sc1
s_mov_b64 exec, -1
s_barrier
ds_read_b32 v32, v3 offset:0
ds_read_b32 v33, v3 offset:288
ds_read_b32 v34, v3 offset:576
ds_read_b32 v35, v3 offset:864
ds_read_b32 v36, v3 offset:8
ds_read_b32 v37, v3 offset:296
ds_read_b32 v38, v3 offset:584
ds_read_b32 v39, v3 offset:872
ds_read_b32 v40, v3 offset:2592
ds_read_b32 v41, v3 offset:2880
ds_read_b32 v42, v3 offset:3168
ds_read_b32 v43, v3 offset:3456
ds_read_b32 v44, v3 offset:2600
ds_read_b32 v45, v3 offset:2888
ds_read_b32 v46, v3 offset:3176
ds_read_b32 v47, v3 offset:3464
s_waitcnt lgkmcnt(8)
ds_read_b32 v48, v3 offset:5184
ds_read_b32 v49, v3 offset:5472
ds_read_b32 v50, v3 offset:5760
ds_read_b32 v51, v3 offset:6048
ds_read_b32 v52, v3 offset:5192
ds_read_b32 v53, v3 offset:5480
ds_read_b32 v54, v3 offset:5768
ds_read_b32 v55, v3 offset:6056
s_waitcnt lgkmcnt(8)
v_add_f32 v32, v32, v40
v_add_f32 v33, v33, v41
v_add_f32 v34, v34, v42
v_add_f32 v35, v35, v43
v_add_f32 v36, v36, v44
v_add_f32 v37, v37, v45
v_add_f32 v38, v38, v46
v_add_f32 v39, v39, v47
ds_read_b32 v56, v3 offset:7776
ds_read_b32 v57, v3 offset:8064
ds_read_b32 v58, v3 offset:8352
ds_read_b32 v59, v3 offset:8640
ds_read_b32 v60, v3 offset:7784
ds_read_b32 v61, v3 offset:8072
ds_read_b32 v62, v3 offset:8360
ds_read_b32 v63, v3 offset:8648
s_waitcnt lgkmcnt(8)
v_add_f32 v32, v32, v48
v_add_f32 v33, v33, v49
v_add_f32 v34, v34, v50
v_add_f32 v35, v35, v51
v_add_f32 v36, v36, v52
v_add_f32 v37, v37, v53
v_add_f32 v38, v38, v54
v_add_f32 v39, v39, v55
ds_read_b32 v64, v3 offset:10368
ds_read_b32 v65, v3 offset:10656
ds_read_b32 v66, v3 offset:10944
ds_read_b32 v67, v3 offset:11232
ds_read_b32 v68, v3 offset:10376
ds_read_b32 v69, v3 offset:10664
ds_read_b32 v70, v3 offset:10952
ds_read_b32 v71, v3 offset:11240
s_waitcnt lgkmcnt(8)
v_add_f32 v32, v32, v56
v_add_f32 v33, v33, v57
v_add_f32 v34, v34, v58
v_add_f32 v35, v35, v59
v_add_f32 v36, v36, v60
v_add_f32 v37, v37, v61
v_add_f32 v38, v38, v62
v_add_f32 v39, v39, v63
ds_read_b32 v72, v3 offset:12960
ds_read_b32 v73, v3 offset:13248
ds_read_b32 v74, v3 offset:13536
ds_read_b32 v75, v3 offset:13824
ds_read_b32 v76, v3 offset:12968
ds_read_b32 v77, v3 offset:13256
ds_read_b32 v78, v3 offset:13544
ds_read_b32 v79, v3 offset:13832
s_waitcnt lgkmcnt(8)
v_add_f32 v32, v32, v64
v_add_f32 v33, v33, v65
v_add_f32 v34, v34, v66
v_add_f32 v35, v35, v67
v_add_f32 v36, v36, v68
v_add_f32 v37, v37, v69
v_add_f32 v38, v38, v70
v_add_f32 v39, v39, v71
ds_read_b32 v80, v3 offset:15552
ds_read_b32 v81, v3 offset:15840
ds_read_b32 v82, v3 offset:16128
ds_read_b32 v83, v3 offset:16416
ds_read_b32 v84, v3 offset:15560
ds_read_b32 v85, v3 offset:15848
ds_read_b32 v86, v3 offset:16136
ds_read_b32 v87, v3 offset:16424
s_waitcnt lgkmcnt(8)
v_add_f32 v32, v32, v72
v_add_f32 v33, v33, v73
v_add_f32 v34, v34, v74
v_add_f32 v35, v35, v75
v_add_f32 v36, v36, v76
v_add_f32 v37, v37, v77
v_add_f32 v38, v38, v78
v_add_f32 v39, v39, v79
ds_read_b32 v88, v3 offset:18144
ds_read_b32 v89, v3 offset:18432
ds_read_b32 v90, v3 offset:18720
ds_read_b32 v91, v3 offset:19008
ds_read_b32 v92, v3 offset:18152
ds_read_b32 v93, v3 offset:18440
ds_read_b32 v94, v3 offset:18728
ds_read_b32 v95, v3 offset:19016
s_waitcnt lgkmcnt(8)
v_add_f32 v32, v32, v80
v_add_f32 v33, v33, v81
v_add_f32 v34, v34, v82
v_add_f32 v35, v35, v83
v_add_f32 v36, v36, v84
v_add_f32 v37, v37, v85
v_add_f32 v38, v38, v86
v_add_f32 v39, v39, v87
s_waitcnt lgkmcnt(0)
v_add_f32 v32, v32, v88
v_add_f32 v33, v33, v89
v_add_f32 v34, v34, v90
v_add_f32 v35, v35, v91
v_add_f32 v36, v36, v92
v_add_f32 v37, v37, v93
v_add_f32 v38, v38, v94
v_add_f32 v39, v39, v95
v_bfi_b32 v32, s3, v10, v32
v_bfi_b32 v33, s3, v10, v33
v_bfi_b32 v34, s3, v10, v34
v_bfi_b32 v35, s3, v10, v35
v_bfi_b32 v36, s3, v10, v36
v_bfi_b32 v37, s3, v10, v37
v_bfi_b32 v38, s3, v10, v38
v_bfi_b32 v39, s3, v10, v39
s_mov_b32 s13, 0
L_xr:
s_waitcnt vmcnt(0)
s_mov_b64 exec, 0xffff
v_cmp_ne_u32 vcc, s63, v13
s_mov_b64 exec, -1
s_cmp_eq_u64 vcc, 0
s_cselect_b32 s62, 1, 0
s_cbranch_scc1 L_xok
s_add_u32 s13, s13, 1
s_cmp_ge_u32 s13, 4
s_cbranch_scc1 L_xok
s_mov_b64 exec, 0xffff
buffer_load_dword v13, v12, s[56:59], s18 offen sc1
s_mov_b64 exec, -1
s_branch L_xr
L_xok:
s_cmp_eq_u32 s62, 0
s_cbranch_scc1 L_l26
buffer_store_dwordx4 v[32:35], v4, s[56:59], s9 offen
buffer_store_dwordx4 v[36:39], v4, s[56:59], s8 offen
L_m26:
s_waitcnt vmcnt(0)
s_mov_b32 s13, 0
L_pq:
buffer_load_dwordx4 v[40:43], v5, s[56:59], s10 offen offset:0 sc1 nt
buffer_load_dwordx4 v[44:47], v5, s[56:59], s11 offen offset:0 sc1 nt
buffer_load_dwordx4 v[48:51], v5, s[56:59], s10 offen offset:512 sc1 nt
buffer_load_dwordx4 v[52:55], v5, s[56:59], s11 offen offset:512 sc1 nt
buffer_load_dwordx4 v[56:59], v5, s[56:59], s10 offen offset:1024 sc1 nt
buffer_load_dwordx4 v[60:63], v5, s[56:59], s11 offen offset:1024 sc1 nt
buffer_load_dwordx4 v[64:67], v5, s[56:59], s10 offen offset:1536 sc1 nt
buffer_load_dwordx4 v[68:71], v5, s[56:59], s11 offen offset:1536 sc1 nt
s_waitcnt vmcnt(0)
v_xor_b32 v1, v40, v10
v_bitop3_b32 v1, v1, v41, v10 bitop3:0xf6
v_bitop3_b32 v1, v1, v42, v10 bitop3:0xf6
v_bitop3_b32 v1, v1, v43, v10 bitop3:0xf6
v_bitop3_b32 v1, v1, v44, v10 bitop3:0xf6
v_bitop3_b32 v1, v1, v45, v10 bitop3:0xf6
v_bitop3_b32 v1, v1, v46, v10 bitop3:0xf6
v_bitop3_b32 v1, v1, v47, v10 bitop3:0xf6
v_bitop3_b32 v1, v1, v48, v10 bitop3:0xf6
v_bitop3_b32 v1, v1, v49, v10 bitop3:0xf6
v_bitop3_b32 v1, v1, v50, v10 bitop3:0xf6
v_bitop3_b32 v1, v1, v51, v10 bitop3:0xf6
v_bitop3_b32 v1, v1, v52, v10 bitop3:0xf6
v_bitop3_b32 v1, v1, v53, v10 bitop3:0xf6
v_bitop3_b32 v1, v1, v54, v10 bitop3:0xf6
v_bitop3_b32 v1, v1, v55, v10 bitop3:0xf6
v_bitop3_b32 v1, v1, v56, v10 bitop3:0xf6
v_bitop3_b32 v1, v1, v57, v10 bitop3:0xf6
v_bitop3_b32 v1, v1, v58, v10 bitop3:0xf6
v_bitop3_b32 v1, v1, v59, v10 bitop3:0xf6
v_bitop3_b32 v1, v1, v60, v10 bitop3:0xf6
v_bitop3_b32 v1, v1, v61, v10 bitop3:0xf6
v_bitop3_b32 v1, v1, v62, v10 bitop3:0xf6
v_bitop3_b32 v1, v1, v63, v10 bitop3:0xf6
v_bitop3_b32 v1, v1, v64, v10 bitop3:0xf6
v_bitop3_b32 v1, v1, v65, v10 bitop3:0xf6
v_bitop3_b32 v1, v1, v66, v10 bitop3:0xf6
v_bitop3_b32 v1, v1, v67, v10 bitop3:0xf6
v_bitop3_b32 v1, v1, v68, v10 bitop3:0xf6
v_bitop3_b32 v1, v1, v69, v10 bitop3:0xf6
v_bitop3_b32 v1, v1, v70, v10 bitop3:0xf6
v_bitop3_b32 v1, v1, v71, v10 bitop3:0xf6
v_and_b32 v1, s3, v1
v_cmp_ne_u32 vcc, 0, v1
s_add_u32 s13, s13, 1
s_cbranch_vccz L_pq_ok
s_mov_b64 exec, vcc
s_sleep 8
s_cmp_lt_u32 s13, 200000
s_cbranch_scc1 L_pq
L_pq_ok:
s_mov_b64 exec, -1
v_mov_b32 v72, 154320
v_mov_b32 v73, s62
ds_write_b32 v72, v73
ds_write_b32 v72, v10 offset:4
v_bfi_b32 v40, s3, 0, v40
v_bfi_b32 v41, s3, 0, v41
v_bfi_b32 v42, s3, 0, v42
v_bfi_b32 v43, s3, 0, v43
v_bfi_b32 v44, s3, 0, v44
v_bfi_b32 v45, s3, 0, v45
v_bfi_b32 v46, s3, 0, v46
v_bfi_b32 v47, s3, 0, v47
v_bfi_b32 v48, s3, 0, v48
v_bfi_b32 v49, s3, 0, v49
v_bfi_b32 v50, s3, 0, v50
v_bfi_b32 v51, s3, 0, v51
v_bfi_b32 v52, s3, 0, v52
v_bfi_b32 v53, s3, 0, v53
v_bfi_b32 v54, s3, 0, v54
v_bfi_b32 v55, s3, 0, v55
v_bfi_b32 v56, s3, 0, v56
v_bfi_b32 v57, s3, 0, v57
v_bfi_b32 v58, s3, 0, v58
v_bfi_b32 v59, s3, 0, v59
v_bfi_b32 v60, s3, 0, v60
v_bfi_b32 v61, s3, 0, v61
v_bfi_b32 v62, s3, 0, v62
v_bfi_b32 v63, s3, 0, v63
v_bfi_b32 v64, s3, 0, v64
v_bfi_b32 v65, s3, 0, v65
v_bfi_b32 v66, s3, 0, v66
v_bfi_b32 v67, s3, 0, v67
v_bfi_b32 v68, s3, 0, v68
v_bfi_b32 v69, s3, 0, v69
v_bfi_b32 v70, s3, 0, v70
v_bfi_b32 v71, s3, 0, v71
v_add_f32 v40, v40, v48
v_add_f32 v56, v56, v64
v_add_f32 v41, v41, v49
v_add_f32 v57, v57, v65
v_add_f32 v42, v42, v50
v_add_f32 v58, v58, v66
v_add_f32 v43, v43, v51
v_add_f32 v59, v59, v67
v_add_f32 v44, v44, v52
v_add_f32 v60, v60, v68
v_add_f32 v45, v45, v53
v_add_f32 v61, v61, v69
v_add_f32 v46, v46, v54
v_add_f32 v62, v62, v70
v_add_f32 v47, v47, v55
v_add_f32 v63, v63, v71
v_add_f32 v40, v40, v56
v_add_f32 v41, v41, v57
v_add_f32 v42, v42, v58
v_add_f32 v43, v43, v59
v_add_f32 v44, v44, v60
v_add_f32 v45, v45, v61
v_add_f32 v46, v46, v62
v_add_f32 v47, v47, v63
v_cvt_pk_bf16_f32 v40, v40, v41
v_cvt_pk_bf16_f32 v41, v42, v43
v_cvt_pk_bf16_f32 v42, v44, v45
v_cvt_pk_bf16_f32 v43, v46, v47
ds_write_b64 v2, v[40:41]
ds_write_b64 v2, v[42:43] offset:512
v_lshlrev_b32 v44, 2, v0
v_add_u32 v44, 152976, v44
v_not_b32 v45, v10
ds_write_b32 v44, v45
s_waitcnt lgkmcnt(0)
s_barrier
s_lshl4_add_u32 s8, s31, s32
s_lshr_b32 s9, s8, 5
s_and_b32 s8, s8, 31
s_lshl2_add_u32 s10, s30, s9
s_lshl_b32 s11, s10, 16
s_lshl_b32 s12, s8, 6
s_add_u32 s11, s11, s12
s_add_u32 s11, s11, 1179648
s_add_u32 s12, s11, 32768
v_lshrrev_b32 v6, 2, v0
v_lshlrev_b32 v2, 11, v6
v_and_b32 v3, 3, v0
v_lshl_add_u32 v2, v3, 4, v2
s_mov_b32 s40, s24
s_mov_b32 s41, s25
s_mov_b32 s42, 8192
s_mov_b32 s43, 0x20000
s_lshl_b32 s14, s10, 8
s_lshl3_add_u32 s14, s8, s14
v_lshrrev_b32 v4, 2, v15
v_lshlrev_b32 v5, 11, v4
v_lshl_add_u32 v5, v3, 1, v5
v_cmp_eq_u32 s[16:17], 1, v4
v_cmp_eq_u32 s[18:19], 2, v4
v_cmp_eq_u32 s[20:21], 3, v4
v_mul_u32_u24 v7, 2176, v6
v_min_u32 v8, 2, v3
v_lshl_add_u32 v7, v8, 4, v7
v_lshlrev_b32 v6, 4, v6
v_add_u32 v6, 152976, v6
s_mul_i32 s8, s35, 34816
s_add_u32 s8, s8, 524288
s_mul_i32 s9, s32, 2176
s_add_u32 s9, s9, s8
v_mov_b32 v9, 133376
v_mov_b32 v11, 152960
v_lshlrev_b32 v12, 4, v0
s_barrier
s_barrier
ds_read_b128 v[32:35], v9 offset:0
ds_read_b128 v[36:39], v9 offset:2592
ds_read_b128 v[40:43], v9 offset:5184
ds_read_b128 v[44:47], v9 offset:7776
ds_read_b128 v[48:51], v9 offset:10368
ds_read_b128 v[52:55], v9 offset:12960
ds_read_b128 v[56:59], v9 offset:15552
ds_read_b128 v[60:63], v9 offset:18144
ds_read_b128 v[64:67], v11
s_waitcnt lgkmcnt(7)
v_add_f32 v32, v32, v36
v_add_f32 v33, v33, v37
v_add_f32 v34, v34, v38
v_add_f32 v35, v35, v39
s_waitcnt lgkmcnt(6)
v_add_f32 v32, v32, v40
v_add_f32 v33, v33, v41
v_add_f32 v34, v34, v42
v_add_f32 v35, v35, v43
s_waitcnt lgkmcnt(5)
v_add_f32 v32, v32, v44
v_add_f32 v33, v33, v45
v_add_f32 v34, v34, v46
v_add_f32 v35, v35, v47
s_waitcnt lgkmcnt(4)
v_add_f32 v32, v32, v48
v_add_f32 v33, v33, v49
v_add_f32 v34, v34, v50
v_add_f32 v35, v35, v51
s_waitcnt lgkmcnt(3)
v_add_f32 v32, v32, v52
v_add_f32 v33, v33, v53
v_add_f32 v34, v34, v54
v_add_f32 v35, v35, v55
s_waitcnt lgkmcnt(2)
v_add_f32 v32, v32, v56
v_add_f32 v33, v33, v57
v_add_f32 v34, v34, v58
v_add_f32 v35, v35, v59
s_waitcnt lgkmcnt(1)
v_add_f32 v32, v32, v60
v_add_f32 v33, v33, v61
v_add_f32 v34, v34, v62
v_add_f32 v35, v35, v63
s_waitcnt lgkmcnt(0)
s_mov_b64 exec, 3
v_and_b32 v32, 0xfffffc00, v64
v_and_b32 v33, 0xfffffc00, v65
v_and_b32 v34, 0xfffffc00, v66
v_and_b32 v35, 0xfffffc00, v67
s_mov_b64 exec, 2
v_sub_f32 v32, v64, v32
v_sub_f32 v33, v65, v33
v_sub_f32 v34, v66, v34
v_sub_f32 v35, v67, v35
s_mov_b64 exec, 7
v_bfi_b32 v32, s3, v10, v32
v_bfi_b32 v33, s3, v10, v33
v_bfi_b32 v34, s3, v10, v34
v_bfi_b32 v35, s3, v10, v35
s_cmp_eq_u32 s62, 0
s_cbranch_scc1 L_l27
buffer_store_dwordx4 v[32:35], v12, s[56:59], s9 offen offset:2048
L_m27:
s_mov_b64 exec, -1
s_barrier
s_waitcnt vmcnt(0)
buffer_load_dwordx4 v[36:39], v7, s[56:59], s8 offen offset:2048 sc1
s_barrier
s_barrier
s_mov_b32 s13, 0
L_ps:
s_waitcnt vmcnt(0)
v_xor_b32 v1, v36, v10
v_bitop3_b32 v1, v1, v37, v10 bitop3:0xf6
v_bitop3_b32 v1, v1, v38, v10 bitop3:0xf6
v_bitop3_b32 v1, v1, v39, v10 bitop3:0xf6
v_and_b32 v1, s3, v1
v_cmp_ne_u32 vcc, 0, v1
s_add_u32 s13, s13, 1
s_cbranch_vccz L_ps_ok
s_mov_b64 exec, vcc
buffer_load_dwordx4 v[36:39], v7, s[56:59], s8 offen offset:2048 sc1
s_cmp_lt_u32 s13, 200000
s_cbranch_scc1 L_ps
L_ps_ok:
s_mov_b64 exec, -1
v_and_b32 v36, 0xfffffc00, v36
v_and_b32 v37, 0xfffffc00, v37
v_and_b32 v38, 0xfffffc00, v38
v_and_b32 v39, 0xfffffc00, v39
v_mov_b32_dpp v40, v36 quad_perm:[0,0,0,0] row_mask:0xf bank_mask:0xf
v_mov_b32_dpp v41, v37 quad_perm:[0,0,0,0] row_mask:0xf bank_mask:0xf
v_mov_b32_dpp v42, v38 quad_perm:[0,0,0,0] row_mask:0xf bank_mask:0xf
v_mov_b32_dpp v43, v39 quad_perm:[0,0,0,0] row_mask:0xf bank_mask:0xf
v_add_f32_dpp v40, v36, v40 quad_perm:[1,1,1,1] row_mask:0xf bank_mask:0xf
v_add_f32_dpp v41, v37, v41 quad_perm:[1,1,1,1] row_mask:0xf bank_mask:0xf
v_add_f32_dpp v42, v38, v42 quad_perm:[1,1,1,1] row_mask:0xf bank_mask:0xf
v_add_f32_dpp v43, v39, v43 quad_perm:[1,1,1,1] row_mask:0xf bank_mask:0xf
v_mov_b32_dpp v44, v36 quad_perm:[2,2,2,2] row_mask:0xf bank_mask:0xf
v_mov_b32_dpp v45, v37 quad_perm:[2,2,2,2] row_mask:0xf bank_mask:0xf
v_mov_b32_dpp v46, v38 quad_perm:[2,2,2,2] row_mask:0xf bank_mask:0xf
v_mov_b32_dpp v47, v39 quad_perm:[2,2,2,2] row_mask:0xf bank_mask:0xf
v_mov_b32 v48, v40
v_mov_b32 v49, v41
v_mov_b32 v50, v42
v_mov_b32 v51, v43
v_max_f32_dpp v48, v48, v48 row_ror:4 row_mask:0xf bank_mask:0xf
v_max_f32_dpp v49, v49, v49 row_ror:4 row_mask:0xf bank_mask:0xf
v_max_f32_dpp v50, v50, v50 row_ror:4 row_mask:0xf bank_mask:0xf
v_max_f32_dpp v51, v51, v51 row_ror:4 row_mask:0xf bank_mask:0xf
v_max_f32_dpp v48, v48, v48 row_ror:8 row_mask:0xf bank_mask:0xf
v_max_f32_dpp v49, v49, v49 row_ror:8 row_mask:0xf bank_mask:0xf
v_max_f32_dpp v50, v50, v50 row_ror:8 row_mask:0xf bank_mask:0xf
v_max_f32_dpp v51, v51, v51 row_ror:8 row_mask:0xf bank_mask:0xf
v_sub_f32 v40, v40, v48
v_sub_f32 v41, v41, v49
v_sub_f32 v42, v42, v50
v_sub_f32 v43, v43, v51
v_exp_f32 v40, v40
v_exp_f32 v41, v41
v_exp_f32 v42, v42
v_exp_f32 v43, v43
s_nop 0
v_mul_f32 v44, v44, v40
v_mul_f32 v45, v45, v41
v_mul_f32 v46, v46, v42
v_mul_f32 v47, v47, v43
v_add_f32_dpp v44, v44, v44 row_ror:4 row_mask:0xf bank_mask:0xf
v_add_f32_dpp v45, v45, v45 row_ror:4 row_mask:0xf bank_mask:0xf
v_add_f32_dpp v46, v46, v46 row_ror:4 row_mask:0xf bank_mask:0xf
v_add_f32_dpp v47, v47, v47 row_ror:4 row_mask:0xf bank_mask:0xf
v_add_f32_dpp v44, v44, v44 row_ror:8 row_mask:0xf bank_mask:0xf
v_add_f32_dpp v45, v45, v45 row_ror:8 row_mask:0xf bank_mask:0xf
v_add_f32_dpp v46, v46, v46 row_ror:8 row_mask:0xf bank_mask:0xf
v_add_f32_dpp v47, v47, v47 row_ror:8 row_mask:0xf bank_mask:0xf
v_rcp_f32 v44, v44
v_rcp_f32 v45, v45
v_rcp_f32 v46, v46
v_rcp_f32 v47, v47
s_nop 0
v_mul_f32 v40, v40, v44
v_mul_f32 v41, v41, v45
v_mul_f32 v42, v42, v46
v_mul_f32 v43, v43, v47
v_bfi_b32 v40, s3, v10, v40
v_bfi_b32 v41, s3, v10, v41
v_bfi_b32 v42, s3, v10, v42
v_bfi_b32 v43, s3, v10, v43
s_mov_b32 exec_lo, 0x11111111
s_mov_b32 exec_hi, 0x11111111
ds_write_b128 v6, v[40:43]
s_mov_b64 exec, -1
s_waitcnt lgkmcnt(0)
s_barrier
s_mov_b32 s13, 0
L_p2:
buffer_load_dwordx4 v[20:23], v2, s[56:59], s11 offen sc1
buffer_load_dwordx4 v[24:27], v2, s[56:59], s12 offen sc1
s_waitcnt vmcnt(0)
v_xor_b32 v1, v20, v10
v_bitop3_b32 v1, v1, v21, v10 bitop3:0xf6
v_bitop3_b32 v1, v1, v22, v10 bitop3:0xf6
v_bitop3_b32 v1, v1, v23, v10 bitop3:0xf6
v_bitop3_b32 v1, v1, v24, v10 bitop3:0xf6
v_bitop3_b32 v1, v1, v25, v10 bitop3:0xf6
v_bitop3_b32 v1, v1, v26, v10 bitop3:0xf6
v_bitop3_b32 v1, v1, v27, v10 bitop3:0xf6
v_and_b32 v1, s3, v1
v_cmp_ne_u32 vcc, 0, v1
s_add_u32 s13, s13, 1
s_cbranch_vccz L_p2_ok
s_mov_b64 exec, vcc
s_sleep 1
s_cmp_lt_u32 s13, 200000
s_cbranch_scc1 L_p2
L_p2_ok:
s_mov_b64 exec, -1
v_bfi_b32 v20, s3, 0, v20
v_bfi_b32 v21, s3, 0, v21
v_bfi_b32 v22, s3, 0, v22
v_bfi_b32 v23, s3, 0, v23
v_bfi_b32 v24, s3, 0, v24
v_bfi_b32 v25, s3, 0, v25
v_bfi_b32 v26, s3, 0, v26
v_bfi_b32 v27, s3, 0, v27
v_add_f32 v60, v20, v24
v_add_f32 v61, v21, v25
v_add_f32 v62, v22, v26
v_add_f32 v63, v23, v27
v_add_f32_dpp v60, v60, v60 row_ror:4 row_mask:0xf bank_mask:0xf
v_add_f32_dpp v61, v61, v61 row_ror:4 row_mask:0xf bank_mask:0xf
v_add_f32_dpp v62, v62, v62 row_ror:4 row_mask:0xf bank_mask:0xf
v_add_f32_dpp v63, v63, v63 row_ror:4 row_mask:0xf bank_mask:0xf
v_add_f32_dpp v60, v60, v60 row_ror:8 row_mask:0xf bank_mask:0xf
v_add_f32_dpp v61, v61, v61 row_ror:8 row_mask:0xf bank_mask:0xf
v_add_f32_dpp v62, v62, v62 row_ror:8 row_mask:0xf bank_mask:0xf
v_add_f32_dpp v63, v63, v63 row_ror:8 row_mask:0xf bank_mask:0xf
v_cndmask_b32 v60, v60, v61, s[16:17]
v_cndmask_b32 v60, v60, v62, s[18:19]
v_cndmask_b32 v60, v60, v63, s[20:21]
v_mov_b32 v61, v60
s_nop 1
v_permlane32_swap_b32 v60, v61
v_add_f32 v60, v60, v61
v_mov_b32 v61, v60
s_nop 1
v_permlane16_swap_b32 v60, v61
v_add_f32 v60, v60, v61
v_cvt_pk_bf16_f32 v60, v60, v60
s_mov_b64 exec, 0xffff
buffer_store_short v60, v5, s[40:43], s14 offen
s_or_b32 s8, s31, s32
s_cmp_lg_u32 s8, 0
s_cbranch_scc1 L_noep
s_mov_b64 exec, 1
buffer_store_dword v10, v12, s[56:59], s61 offen sc1
L_noep:
L_end:
s_endpgm
L_l25:
buffer_store_dwordx4 v[100:103], v7, s[56:59], s10 offen sc1
s_branch L_m25
L_l26:
buffer_store_dwordx4 v[32:35], v4, s[56:59], s9 offen sc1
buffer_store_dwordx4 v[36:39], v4, s[56:59], s8 offen sc1
s_branch L_m26
L_l27:
buffer_store_dwordx4 v[32:35], v12, s[56:59], s9 offen offset:2048 sc1
s_branch L_m27
.section .rodata,"a"
.p2align 6
.amdhsa_kernel concat_heads__gqa_block_cached__gqa_block_cached__decode_kernel
  .amdhsa_next_free_vgpr 164
  .amdhsa_next_free_sgpr 100
  .amdhsa_accum_offset 164
  .amdhsa_group_segment_fixed_size 0
  .amdhsa_kernarg_size 104
  .amdhsa_user_sgpr_count 2
  .amdhsa_user_sgpr_kernarg_segment_ptr 1
  .amdhsa_system_sgpr_workgroup_id_x 1
.end_amdhsa_kernel
```
